```python
import torch

def _softmax(x, axis=-1):
    return torch.softmax(x, dim=axis)
def _gelu(x):
    return torch.nn.functional.gelu(x, approximate="tanh")
def _silu(x):
    return torch.nn.functional.silu(x)
def _sigmoid(x):
    return torch.sigmoid(x)
def _layernorm(x, axis=-1, eps=1e-5):
    m = x.mean(dim=axis, keepdim=True)
    v = x.var(dim=axis, keepdim=True, unbiased=False)
    return (x - m) / torch.sqrt(v + eps)
def _scatter_add(tgt, idx, src, axis=0):
    return tgt.clone().index_add_(axis, idx, src)
def _segment_sum(src, seg, n):
    out = torch.zeros((n,) + src.shape[1:], dtype=src.dtype)
    return out.index_add_(0, seg, src)
def _pad(x, pw):
    flat = tuple(v for pair in reversed(pw) for v in pair)
    return torch.nn.functional.pad(x, flat)

kernel_name = 'parallel_sum__sliding_block_cached__dense_activation_silu__decode'

def setup_inputs():

    _w = (lambda a: (lambda t: t.to(torch.bfloat16) if t.is_floating_point() else t)(torch.as_tensor(a)))
    def _A_setup():
        B, Sq, D = 1, 1, 640
        Hq, Hkv, Sk, Dh = 32, 32, 8192, 128
        assert Hq % Hkv == 0, (Hq, Hkv)
        return {
            "x": _w((lambda *s: torch.randn(*s, dtype=torch.bfloat16) * 0.05)(B, Sq, D)),
            "k_cache": _w((lambda *s: torch.randn(*s, dtype=torch.bfloat16) * 3.2)(B, Hkv, Sk, Dh)),
            "v_cache": _w((lambda *s: torch.randn(*s, dtype=torch.bfloat16) * 0.8)(B, Hkv, Sk, Dh)),
            "wq": _w((lambda *s: torch.randn(*s, dtype=torch.bfloat16) * 3.2)(D, Hq * Dh) * (D ** -0.5)),
            "wo": _w((lambda *s: torch.randn(*s, dtype=torch.bfloat16) * 0.8)(Hq * Dh, D) * ((Hq * Dh) ** -0.5)),
        }
    _A_in = _A_setup()

    def _B_setup():
        B, S, D, F = 1, 1, 640, 1728
        return {
            "x": _w((lambda *s: torch.randn(*s, dtype=torch.bfloat16) * 0.05)(B, S, D)),
            "w1": _w((lambda *s: torch.randn(*s, dtype=torch.bfloat16) * 3.2)(D, F) * (D ** -0.5)),
            "w2": _w((lambda *s: torch.randn(*s, dtype=torch.bfloat16) * 0.2)(F, D) * (F ** -0.5)),
        }
    _B_in = _B_setup()

    return {
        "A_x": _A_in["x"],
        "A_k_cache": _A_in["k_cache"],
        "A_v_cache": _A_in["v_cache"],
        "A_wq": _A_in["wq"],
        "A_wo": _A_in["wo"],
        "B_x": _B_in["x"],
        "B_w1": _B_in["w1"],
        "B_w2": _B_in["w2"],
    }

def reference(A_x, A_k_cache, A_v_cache, A_wq, A_wo, B_x, B_w1, B_w2):
    def _A_ref(x, k_cache, v_cache, wq, wo):
        B, Sq, D = x.shape
        Hq, Dh = 32, 128
        Hkv, Sk = k_cache.shape[1], k_cache.shape[2]
        W = min(4096, max(256, Sk // 4))
        rep = Hq // Hkv
        q = (lambda x, *d: x.permute(*d))((x @ wq).reshape(B, Sq, Hq, Dh), 0, 2, 1, 3)
        k = (lambda x, n, axis: torch.repeat_interleave(x, n, dim=axis))(k_cache[:, :, Sk - W:, :], rep, axis=1)
        v = (lambda x, n, axis: torch.repeat_interleave(x, n, dim=axis))(v_cache[:, :, Sk - W:, :], rep, axis=1)
        scores = torch.einsum("bhqd,bhkd->bhqk", q, k) * (Dh ** -0.5)
        p = _softmax(scores, axis=-1)
        o = torch.einsum("bhqk,bhkd->bhqd", p, v)
        return (lambda x, *d: x.permute(*d))(o, 0, 2, 1, 3).reshape(B, Sq, Hq * Dh) @ wo

    def _B_ref(x, w1, w2):
        h = torch.einsum("bsd,df->bsf", x, w1)
        h = _silu(h)
        out = torch.einsum("bsf,fd->bsd", h, w2)
        return out

    x = A_x
    xn = _layernorm(x, axis=-1)
    return x + _A_ref(xn, A_k_cache, A_v_cache, A_wq, A_wo) + _B_ref(xn, B_w1, B_w2)
```

```asm
; @launch grid=(256,1,1) block=(512,1,1) lds=9728
.amdgcn_target "amdgcn-amd-amdhsa--gfx950"
.text
.globl parallel_sum__sliding_block_cached__dense_activation_silu__decode_kernel
.p2align 8
.type parallel_sum__sliding_block_cached__dense_activation_silu__decode_kernel,@function
parallel_sum__sliding_block_cached__dense_activation_silu__decode_kernel:
    s_cmp_ge_u32 s2, 256
    s_cbranch_scc1 L_end
    v_lshrrev_b32 v17, 6, v0
    v_and_b32 v1, 63, v0
    s_and_b32 s44, s2, 7
    s_lshr_b32 s50, s2, 6
    s_lshl_b32 s50, s50, 3
    s_or_b32 s44, s44, s50
    v_readfirstlane_b32 s46, v17
    s_bfe_u32 s45, s2, 0x30003
    v_and_b32 v2, 15, v1
    v_lshrrev_b32 v3, 4, v1
    s_cmp_ge_u32 s46, 4
    s_cbranch_scc1 L_kv
    s_load_dwordx2 s[4:5], s[0:1], 0
    s_load_dwordx2 s[16:17], s[0:1], 24
    s_load_dwordx2 s[24:25], s[0:1], 48
    s_load_dwordx2 s[40:41], s[0:1], 80
    s_load_dwordx2 s[20:21], s[0:1], 32
    s_load_dwordx2 s[28:29], s[0:1], 56
    s_load_dwordx2 s[32:33], s[0:1], 64
    s_lshl_b32 s47, s44, 3
    s_lshl_b32 s64, s44, 14
    s_or_b32 s47, s47, s45
    s_mov_b32 s6, 1280
    s_mov_b32 s7, 0x20000
    s_mov_b32 s18, 5242880
    s_mov_b32 s19, 0x20000
    s_mov_b32 s22, 5242880
    s_mov_b32 s23, 0x20000
    s_mov_b32 s34, 1280
    s_mov_b32 s35, 0x20000
    s_mov_b32 s42, 268435456
    s_mov_b32 s43, 0x20000
    s_cmp_lt_u32 s44, 27
    s_cselect_b32 s26, 2211840, 0
    s_cselect_b32 s30, 2211840, 0
    s_mov_b32 s27, 0x20000
    s_mov_b32 s31, 0x20000
    v_lshlrev_b32 v17, 4, v2
    v_lshl_add_u32 v4, v3, 13, v17
    v_mov_b32 v18, 0x80000000
    v_mul_u32_u24 v5, 3456, v3
    v_add_u32 v5, v5, v17
    v_mul_u32_u24 v6, 1280, v3
    v_add_u32 v6, v6, v17
    v_cmp_gt_u32 vcc, 8, v2
    s_nop 1
    v_cndmask_b32 v5, v18, v5, vcc
    v_cmp_gt_u32 vcc, 10, v2
    s_nop 1
    v_cndmask_b32 v6, v18, v6, vcc
    v_lshlrev_b32 v19, 3, v1
    v_lshlrev_b32 v20, 2, v1
    v_mov_b32 v21, 0
    s_mul_i32 s50, s45, 80
    s_lshl_b32 s51, s46, 2
    s_add_u32 s50, s50, s51
    s_lshl_b32 s54, s50, 13
    s_lshl_b32 s51, s44, 8
    s_add_u32 s54, s54, s51
    s_mul_i32 s55, s50, 3456
    s_lshl_b32 s51, s44, 7
    s_add_u32 s55, s55, s51
    s_waitcnt lgkmcnt(0)
    buffer_load_dwordx2 v[96:97], v19, s[4:7], 0 offen
    buffer_load_dwordx2 v[98:99], v19, s[4:7], 0 offen offset:512
    buffer_load_dword v100, v20, s[4:7], 0 offen offset:1024
    buffer_load_dword v101, v21, s[40:43], 0 offen sc1
    buffer_load_dwordx4 v[32:35], v4, s[16:19], s54 offen nt
    buffer_load_dwordx4 v[52:55], v5, s[24:27], s55 offen nt
    s_add_u32 s54, s54, 131072
    s_add_u32 s55, s55, 55296
    buffer_load_dwordx4 v[36:39], v4, s[16:19], s54 offen nt
    buffer_load_dwordx4 v[56:59], v5, s[24:27], s55 offen nt
    s_add_u32 s54, s54, 131072
    s_add_u32 s55, s55, 55296
    buffer_load_dwordx4 v[40:43], v4, s[16:19], s54 offen nt
    buffer_load_dwordx4 v[60:63], v5, s[24:27], s55 offen nt
    s_add_u32 s54, s54, 131072
    s_add_u32 s55, s55, 55296
    buffer_load_dwordx4 v[44:47], v4, s[16:19], s54 offen nt
    buffer_load_dwordx4 v[64:67], v5, s[24:27], s55 offen nt
    s_add_u32 s54, s54, 131072
    s_add_u32 s55, s55, 55296
    buffer_load_dwordx4 v[48:51], v4, s[16:19], s54 offen nt
    buffer_load_dwordx4 v[68:71], v5, s[24:27], s55 offen nt
    v_and_b32 v17, 1, v2
    v_lshlrev_b32 v17, 4, v17
    v_mov_b32 v18, 0xffff
    v_lshlrev_b32 v17, v17, v18
    v_lshrrev_b32 v18, 1, v2
    v_cmp_eq_u32 vcc, 0, v18
    s_nop 1
    v_cndmask_b32 v10, 0, v17, vcc
    v_cmp_eq_u32 vcc, 1, v18
    s_nop 1
    v_cndmask_b32 v11, 0, v17, vcc
    v_cmp_eq_u32 vcc, 2, v18
    s_nop 1
    v_cndmask_b32 v12, 0, v17, vcc
    v_cmp_eq_u32 vcc, 3, v18
    s_nop 1
    v_cndmask_b32 v13, 0, v17, vcc
    v_and_b32 v7, 7, v1
    v_lshrrev_b32 v8, 3, v1
    s_mul_i32 s52, s45, 160
    s_mul_i32 s56, s44, 163840
    s_mul_i32 s53, s46, 40960
    s_add_u32 s56, s56, s53
    s_add_u32 s56, s56, s52
    s_mul_i32 s57, s44, 81920
    s_mul_i32 s53, s46, 20480
    s_add_u32 s57, s57, s53
    s_add_u32 s57, s57, s52
    v_lshlrev_b32 v9, 5, v2
    v_lshl_add_u32 v9, v3, 4, v9
    s_lshl_b32 s50, s50, 1
    v_lshl_add_u32 v16, v3, 1, s50
    s_waitcnt vmcnt(11)
    ds_write_b64 v19, v[96:97] offset:0
    ds_write_b64 v19, v[98:99] offset:512
    ds_write_b32 v20, v100 offset:1024
    ds_read_u16 v102, v16 offset:0
    ds_read_u16 v103, v16 offset:32
    ds_read_u16 v104, v16 offset:64
    ds_read_u16 v105, v16 offset:96
    ds_read_u16 v106, v16 offset:128
    v_lshlrev_b32 v17, 16, v96
    v_and_b32 v18, 0xffff0000, v96
    v_lshlrev_b32 v19, 16, v97
    v_and_b32 v20, 0xffff0000, v97
    v_lshlrev_b32 v21, 16, v98
    v_and_b32 v22, 0xffff0000, v98
    v_lshlrev_b32 v23, 16, v99
    v_and_b32 v24, 0xffff0000, v99
    v_lshlrev_b32 v25, 16, v100
    v_and_b32 v26, 0xffff0000, v100
    v_add_f32 v27, v17, v18
    v_add_f32 v28, v19, v20
    v_add_f32 v27, v27, v21
    v_add_f32 v28, v28, v22
    v_add_f32 v27, v27, v23
    v_add_f32 v28, v28, v24
    v_add_f32 v27, v27, v25
    v_add_f32 v28, v28, v26
    v_add_f32 v27, v27, v28
    s_nop 1
    v_add_f32_dpp v27, v27, v27 quad_perm:[1,0,3,2] row_mask:0xf bank_mask:0xf
    s_nop 1
    v_add_f32_dpp v27, v27, v27 quad_perm:[2,3,0,1] row_mask:0xf bank_mask:0xf
    s_nop 1
    v_add_f32_dpp v27, v27, v27 row_half_mirror row_mask:0xf bank_mask:0xf
    s_nop 1
    v_add_f32_dpp v27, v27, v27 row_mirror row_mask:0xf bank_mask:0xf
    s_nop 1
    v_add_f32_dpp v27, v27, v27 row_bcast:15 row_mask:0xa bank_mask:0xf
    s_nop 1
    v_add_f32_dpp v27, v27, v27 row_bcast:31 row_mask:0xc bank_mask:0xf
    s_nop 0
    v_readlane_b32 s53, v27, 63
    v_mov_b32 v28, 0x3acccccd
    s_nop 0
    v_mul_f32 v27, s53, v28
    v_sub_f32 v17, v17, v27
    v_sub_f32 v18, v18, v27
    v_sub_f32 v19, v19, v27
    v_sub_f32 v20, v20, v27
    v_sub_f32 v21, v21, v27
    v_sub_f32 v22, v22, v27
    v_sub_f32 v23, v23, v27
    v_sub_f32 v24, v24, v27
    v_sub_f32 v25, v25, v27
    v_sub_f32 v26, v26, v27
    v_mul_f32 v29, v17, v17
    v_mul_f32 v30, v18, v18
    v_fmac_f32 v29, v19, v19
    v_fmac_f32 v30, v20, v20
    v_fmac_f32 v29, v21, v21
    v_fmac_f32 v30, v22, v22
    v_fmac_f32 v29, v23, v23
    v_fmac_f32 v30, v24, v24
    v_fmac_f32 v29, v25, v25
    v_fmac_f32 v30, v26, v26
    v_add_f32 v29, v29, v30
    v_cvt_pk_bf16_f32 v27, v27, v27
    s_nop 0
    v_add_f32_dpp v29, v29, v29 quad_perm:[1,0,3,2] row_mask:0xf bank_mask:0xf
    s_nop 1
    v_add_f32_dpp v29, v29, v29 quad_perm:[2,3,0,1] row_mask:0xf bank_mask:0xf
    s_nop 1
    v_add_f32_dpp v29, v29, v29 row_half_mirror row_mask:0xf bank_mask:0xf
    s_nop 1
    v_add_f32_dpp v29, v29, v29 row_mirror row_mask:0xf bank_mask:0xf
    s_nop 1
    v_add_f32_dpp v29, v29, v29 row_bcast:15 row_mask:0xa bank_mask:0xf
    s_nop 1
    v_add_f32_dpp v29, v29, v29 row_bcast:31 row_mask:0xc bank_mask:0xf
    v_and_b32 v27, 0xffff0000, v27
    v_readlane_b32 s53, v29, 63
    s_nop 1
    v_mul_f32 v28, s53, v28
    v_cvt_pk_bf16_f32 v28, v28, v28
    v_and_b32 v28, 0xffff0000, v28
    v_add_f32 v28, 0x3727c5ac, v28
    v_cvt_pk_bf16_f32 v28, v28, v28
    v_and_b32 v28, 0xffff0000, v28
    v_sqrt_f32 v28, v28
    s_nop 0
    v_cvt_pk_bf16_f32 v28, v28, v28
    v_and_b32 v28, 0xffff0000, v28
    v_rcp_f32 v28, v28
    s_waitcnt lgkmcnt(0)
    v_lshlrev_b32 v102, 16, v102
    v_lshlrev_b32 v103, 16, v103
    v_lshlrev_b32 v104, 16, v104
    v_lshlrev_b32 v105, 16, v105
    v_lshlrev_b32 v106, 16, v106
    v_sub_f32 v102, v102, v27
    v_sub_f32 v103, v103, v27
    v_sub_f32 v104, v104, v27
    v_sub_f32 v105, v105, v27
    v_sub_f32 v106, v106, v27
    v_cvt_pk_bf16_f32 v102, v102, v102
    v_cvt_pk_bf16_f32 v103, v103, v103
    v_cvt_pk_bf16_f32 v104, v104, v104
    v_cvt_pk_bf16_f32 v105, v105, v105
    v_cvt_pk_bf16_f32 v106, v106, v106
    v_and_b32 v102, 0xffff0000, v102
    v_and_b32 v103, 0xffff0000, v103
    v_and_b32 v104, 0xffff0000, v104
    v_and_b32 v105, 0xffff0000, v105
    v_and_b32 v106, 0xffff0000, v106
    v_mul_f32 v102, v102, v28
    v_mul_f32 v103, v103, v28
    v_mul_f32 v104, v104, v28
    v_mul_f32 v105, v105, v28
    v_mul_f32 v106, v106, v28
    v_cvt_pk_bf16_f32 v102, v102, v102
    v_cvt_pk_bf16_f32 v103, v103, v103
    v_cvt_pk_bf16_f32 v104, v104, v104
    v_cvt_pk_bf16_f32 v105, v105, v105
    v_cvt_pk_bf16_f32 v106, v106, v106
    v_and_b32 v72, v102, v10
    v_and_b32 v73, v102, v11
    v_and_b32 v74, v102, v12
    v_and_b32 v75, v102, v13
    v_and_b32 v76, v103, v10
    v_and_b32 v77, v103, v11
    v_and_b32 v78, v103, v12
    v_and_b32 v79, v103, v13
    v_and_b32 v80, v104, v10
    v_and_b32 v81, v104, v11
    v_and_b32 v82, v104, v12
    v_and_b32 v83, v104, v13
    v_and_b32 v84, v105, v10
    v_and_b32 v85, v105, v11
    v_and_b32 v86, v105, v12
    v_and_b32 v87, v105, v13
    v_and_b32 v88, v106, v10
    v_and_b32 v89, v106, v11
    v_and_b32 v90, v106, v12
    v_and_b32 v91, v106, v13
    s_waitcnt vmcnt(10)
    v_readfirstlane_b32 s58, v101
    s_waitcnt vmcnt(8)
    v_mfma_f32_16x16x32_bf16 v[108:111], v[72:75], v[32:35], 0
    v_mfma_f32_16x16x32_bf16 v[112:115], v[72:75], v[52:55], 0
    s_waitcnt vmcnt(6)
    v_mfma_f32_16x16x32_bf16 v[108:111], v[76:79], v[36:39], v[108:111]
    v_mfma_f32_16x16x32_bf16 v[112:115], v[76:79], v[56:59], v[112:115]
    s_waitcnt vmcnt(4)
    v_mfma_f32_16x16x32_bf16 v[108:111], v[80:83], v[40:43], v[108:111]
    v_mfma_f32_16x16x32_bf16 v[112:115], v[80:83], v[60:63], v[112:115]
    s_waitcnt vmcnt(2)
    v_mfma_f32_16x16x32_bf16 v[108:111], v[84:87], v[44:47], v[108:111]
    v_mfma_f32_16x16x32_bf16 v[112:115], v[84:87], v[64:67], v[112:115]
    s_waitcnt vmcnt(0)
    v_mfma_f32_16x16x32_bf16 v[108:111], v[88:91], v[48:51], v[108:111]
    v_mfma_f32_16x16x32_bf16 v[112:115], v[88:91], v[68:71], v[112:115]
    s_add_u32 s58, s58, 1
    s_mul_i32 s53, s46, 768
    v_add_u32 v18, s53, v9
    s_lshl_b32 s53, s46, 2
    v_mov_b32 v19, s53
    v_mov_b32 v20, s58
    v_mov_b32 v31, 4352
    s_mov_b32 exec_hi, 0
    ds_write_b128 v18, v[108:111] offset:1280
    s_mov_b32 exec_lo, 0x00ff00ff
    ds_write_b128 v18, v[112:115] offset:1792
    s_mov_b32 exec_lo, 1
    ds_write_b32 v19, v20 offset:4352
    s_mov_b64 exec, -1
    s_mov_b32 s59, 1048576
L_sb:
    ds_read_b128 v[20:23], v31
    s_waitcnt lgkmcnt(0)
    v_xor_b32 v28, s58, v20
    v_xor_b32 v29, s58, v21
    v_or_b32 v28, v28, v29
    v_xor_b32 v29, s58, v22
    v_or_b32 v28, v28, v29
    v_xor_b32 v29, s58, v23
    v_or_b32 v28, v28, v29
    v_cmp_ne_u32 vcc, 0, v28
    s_cbranch_vccz L_sb_ok
    s_sub_u32 s59, s59, 1
    s_cmp_lg_u32 s59, 0
    s_cbranch_scc1 L_sb
L_sb_ok:
    s_mul_i32 s53, s46, 48
    v_add_u32 v17, s53, v1
    v_lshlrev_b32 v18, 2, v17
    s_mov_b32 exec_lo, -1
    s_mov_b32 exec_hi, 0xffff
    ds_read_b32 v20, v18 offset:1280
    ds_read_b32 v21, v18 offset:2048
    ds_read_b32 v22, v18 offset:2816
    ds_read_b32 v23, v18 offset:3584
    s_lshl_b32 s53, s47, 11
    s_add_u32 s53, s53, 65536
    v_lshlrev_b32 v18, 3, v17
    s_waitcnt lgkmcnt(0)
    v_add_f32 v20, v20, v21
    v_add_f32 v22, v22, v23
    v_add_f32 v24, v20, v22
    v_mov_b32 v25, s58
    buffer_store_dwordx2 v[24:25], v18, s[40:43], s53 offen sc1
    s_mov_b64 exec, -1
    v_lshlrev_b32 v121, 11, v8
    s_lshl_b32 s53, s46, 8
    v_lshl_add_u32 v120, v7, 4, v121
    v_add_u32 v122, s53, v120
    s_lshl_b32 s53, s46, 7
    v_add_u32 v120, s53, v120
    s_add_u32 s52, s64, 65536
    s_mov_b32 s59, 131072
    s_barrier
L_ex1_full:
    buffer_load_dwordx4 v[32:35], v122, s[40:43], s52 offen sc1
    buffer_load_dwordx4 v[36:39], v122, s[40:43], s52 offen offset:128 sc1
    buffer_load_dwordx4 v[40:43], v120, s[40:43], s52 offen offset:1024 sc1
    s_waitcnt vmcnt(0)
    v_xor_b32 v28, s58, v33
    v_xor_b32 v29, s58, v35
    v_or_b32 v28, v28, v29
    v_xor_b32 v29, s58, v37
    v_or_b32 v28, v28, v29
    v_xor_b32 v29, s58, v39
    v_or_b32 v28, v28, v29
    v_xor_b32 v29, s58, v41
    v_or_b32 v28, v28, v29
    v_xor_b32 v29, s58, v43
    v_or_b32 v28, v28, v29
    v_cmp_ne_u32 vcc, 0, v28
    s_cbranch_vccz L_ex1_ok
    s_sub_u32 s59, s59, 1
    s_cmp_gt_i32 s59, 0
    s_cbranch_scc1 L_ex1_full
L_ex1_ok:
    v_add_f32_dpp v32, v32, v32 row_ror:8 row_mask:0xf bank_mask:0xf
    v_add_f32_dpp v34, v34, v34 row_ror:8 row_mask:0xf bank_mask:0xf
    v_add_f32_dpp v36, v36, v36 row_ror:8 row_mask:0xf bank_mask:0xf
    v_add_f32_dpp v38, v38, v38 row_ror:8 row_mask:0xf bank_mask:0xf
    v_add_f32_dpp v40, v40, v40 row_ror:8 row_mask:0xf bank_mask:0xf
    v_add_f32_dpp v42, v42, v42 row_ror:8 row_mask:0xf bank_mask:0xf
    v_permlane16_swap_b32 v32, v34
    v_permlane16_swap_b32 v36, v38
    v_permlane16_swap_b32 v40, v42
    v_add_f32 v32, v32, v34
    v_add_f32 v36, v36, v38
    v_add_f32 v40, v40, v42
    v_mov_b32 v28, v32
    v_mov_b32 v29, v36
    v_mov_b32 v30, v40
    v_permlane32_swap_b32 v32, v28
    v_permlane32_swap_b32 v36, v29
    v_permlane32_swap_b32 v40, v30
    v_add_f32 v32, v32, v28
    v_add_f32 v36, v36, v29
    v_add_f32 v40, v40, v30
    v_cvt_pk_bf16_f32 v32, v32, v32
    v_cvt_pk_bf16_f32 v36, v36, v36
    v_and_b32 v28, 1, v3
    v_lshlrev_b32 v28, 1, v28
    v_lshl_add_u32 v123, v7, 2, v28
    s_lshl_b32 s53, s46, 6
    v_add_u32 v28, s53, v123
    ds_write_b16 v28, v32 offset:4608
    ds_write_b16 v28, v36 offset:4640
    v_cvt_pk_bf16_f32 v40, v40, v40
    v_and_b32 v40, 0xffff0000, v40
    v_mul_f32 v41, 0xbfb8aa3b, v40
    v_exp_f32 v41, v41
    s_nop 0
    v_add_f32 v41, 1.0, v41
    v_rcp_f32 v41, v41
    s_nop 0
    v_mul_f32 v40, v40, v41
    v_cvt_pk_bf16_f32 v40, v40, v40
    s_nop 1
    v_mov_b32_dpp v40, v40 row_shl:1 row_mask:0xc bank_mask:0xf
    s_nop 1
    v_and_b32_dpp v72, v40, v10 row_newbcast:0 row_mask:0xf bank_mask:0xf
    v_and_b32_dpp v73, v40, v11 row_newbcast:0 row_mask:0xf bank_mask:0xf
    v_and_b32_dpp v74, v40, v12 row_newbcast:0 row_mask:0xf bank_mask:0xf
    v_and_b32_dpp v75, v40, v13 row_newbcast:0 row_mask:0xf bank_mask:0xf
    v_and_b32_dpp v76, v40, v10 row_newbcast:2 row_mask:0xf bank_mask:0xf
    v_and_b32_dpp v77, v40, v11 row_newbcast:2 row_mask:0xf bank_mask:0xf
    v_and_b32_dpp v78, v40, v12 row_newbcast:2 row_mask:0xf bank_mask:0xf
    v_and_b32_dpp v79, v40, v13 row_newbcast:2 row_mask:0xf bank_mask:0xf
    v_and_b32_dpp v80, v40, v10 row_newbcast:4 row_mask:0xf bank_mask:0xf
    v_and_b32_dpp v81, v40, v11 row_newbcast:4 row_mask:0xf bank_mask:0xf
    v_and_b32_dpp v82, v40, v12 row_newbcast:4 row_mask:0xf bank_mask:0xf
    v_and_b32_dpp v83, v40, v13 row_newbcast:4 row_mask:0xf bank_mask:0xf
    v_and_b32_dpp v84, v40, v10 row_newbcast:6 row_mask:0xf bank_mask:0xf
    v_and_b32_dpp v85, v40, v11 row_newbcast:6 row_mask:0xf bank_mask:0xf
    v_and_b32_dpp v86, v40, v12 row_newbcast:6 row_mask:0xf bank_mask:0xf
    v_and_b32_dpp v87, v40, v13 row_newbcast:6 row_mask:0xf bank_mask:0xf
    s_waitcnt lgkmcnt(0)
    s_barrier
    s_barrier
    buffer_load_dwordx4 v[128:131], v6, s[28:31], s57 offen nt
    s_add_u32 s57, s57, 5120
    buffer_load_dwordx4 v[132:135], v6, s[28:31], s57 offen nt
    s_add_u32 s57, s57, 5120
    buffer_load_dwordx4 v[136:139], v6, s[28:31], s57 offen nt
    s_add_u32 s57, s57, 5120
    buffer_load_dwordx4 v[140:143], v6, s[28:31], s57 offen nt
    buffer_load_dwordx4 v[144:147], v6, s[20:23], s56 offen nt
    s_add_u32 s56, s56, 5120
    buffer_load_dwordx4 v[148:151], v6, s[20:23], s56 offen nt
    s_add_u32 s56, s56, 5120
    buffer_load_dwordx4 v[152:155], v6, s[20:23], s56 offen nt
    s_add_u32 s56, s56, 5120
    s_lshl_b32 s53, s46, 7
    v_lshl_add_u32 v20, v1, 4, s53
    v_mov_b32 v21, 512
    v_cmp_eq_u32 vcc, 8, v1
    s_nop 1
    v_cndmask_b32 v20, v20, v21, vcc
    s_cmp_eq_u32 s46, 0
    s_cselect_b32 s51, 0x100, 0
    s_or_b32 s51, s51, 0xff
    s_lshl_b32 s53, s47, 10
    s_add_u32 s53, s53, 589824
    s_lshl_b32 s52, s44, 13
    s_add_u32 s52, s52, 589824
    s_and_b32 s65, s58, 0xff
    s_mov_b32 s66, 0x07060500
    v_mov_b32 v21, s65
    v_mov_b32 v22, 0xff
    v_lshlrev_b32 v121, 10, v8
    s_lshl_b32 s50, s46, 7
    v_lshl_add_u32 v120, v7, 4, v121
    v_add_u32 v120, s50, v120
    s_barrier
    s_mov_b32 exec_hi, 0
    s_mov_b32 exec_lo, s51
    ds_read_b128 v[32:35], v20 offset:5120
    ds_read_b128 v[36:39], v20 offset:5648
    ds_read_b128 v[40:43], v20 offset:6176
    ds_read_b128 v[44:47], v20 offset:6704
    s_waitcnt lgkmcnt(0)
    v_pk_add_f32 v[32:33], v[32:33], v[36:37]
    v_pk_add_f32 v[34:35], v[34:35], v[38:39]
    v_pk_add_f32 v[40:41], v[40:41], v[44:45]
    v_pk_add_f32 v[42:43], v[42:43], v[46:47]
    v_pk_add_f32 v[32:33], v[32:33], v[40:41]
    v_pk_add_f32 v[34:35], v[34:35], v[42:43]
    v_perm_b32 v24, v32, v21, s66
    v_perm_b32 v25, v33, v21, s66
    v_perm_b32 v26, v34, v21, s66
    v_perm_b32 v27, v35, v21, s66
    v_writelane_b32 v26, s58, 8
    s_add_u32 s50, s53, 458752
    buffer_store_dwordx4 v[24:27], v20, s[40:43], s50 offen
    buffer_store_dwordx4 v[24:27], v20, s[40:43], s53 offen sc1
    s_mov_b64 exec, -1
    s_add_u32 s67, s52, 458752
    buffer_load_dwordx4 v[156:159], v6, s[20:23], s56 offen nt
    s_add_u32 s56, s56, 5120
    buffer_load_dwordx4 v[160:163], v6, s[20:23], s56 offen nt
    s_add_u32 s56, s56, 5120
    buffer_load_dwordx4 v[164:167], v6, s[20:23], s56 offen nt
    s_add_u32 s56, s56, 5120
    buffer_load_dwordx4 v[168:171], v6, s[20:23], s56 offen nt
    s_add_u32 s56, s56, 5120
    buffer_load_dwordx4 v[172:175], v6, s[20:23], s56 offen nt
    s_waitcnt vmcnt(2)
    buffer_load_dwordx4 v[32:35], v120, s[40:43], s67 offen sc1
    buffer_load_dwordx4 v[36:39], v121, s[40:43], s67 offen offset:512 sc1
    s_waitcnt vmcnt(12)
    v_mfma_f32_16x16x32_bf16 v[116:119], v[72:75], v[128:131], 0
    v_mfma_f32_16x16x32_bf16 v[116:119], v[76:79], v[132:135], v[116:119]
    v_mfma_f32_16x16x32_bf16 v[116:119], v[80:83], v[136:139], v[116:119]
    v_mfma_f32_16x16x32_bf16 v[116:119], v[84:87], v[140:143], v[116:119]
    s_lshl_b32 s53, s46, 9
    v_add_u32 v20, s53, v9
    s_mul_i32 s53, s46, 80
    v_lshl_add_u32 v23, v1, 4, s53
    s_mul_i32 s53, s46, 5
    v_add_u32 v19, s53, v1
    v_lshrrev_b32 v18, 2, v19
    v_and_b32 v19, 3, v19
    v_lshlrev_b32 v19, 4, v19
    v_lshl_add_u32 v19, v18, 11, v19
    s_mul_i32 s53, s45, 10240
    s_lshl_b32 s50, s44, 6
    s_add_u32 s53, s53, s50
    s_add_u32 s53, s53, 851968
    v_mov_b32 v31, 0xffffff00
    s_waitcnt vmcnt(0)
    v_bitop3_b32 v28, v32, v33, v21 bitop3:0x7e
    v_bitop3_b32 v29, v34, v35, v21 bitop3:0x7e
    v_or_b32 v28, v28, v29
    v_bitop3_b32 v29, v36, v37, v21 bitop3:0x7e
    v_or_b32 v28, v28, v29
    v_xor_b32 v29, s58, v38
    v_and_or_b32 v28, v28, v22, v29
    v_cmp_ne_u32 vcc, 0, v28
    s_cbranch_vccz L_ex2_ok
    s_mov_b32 s59, 131072
L_ex2_retry:
    buffer_load_dwordx4 v[32:35], v120, s[40:43], s67 offen sc1
    buffer_load_dwordx4 v[36:39], v121, s[40:43], s67 offen offset:512 sc1
    s_waitcnt vmcnt(0)
    v_bitop3_b32 v28, v32, v33, v21 bitop3:0x7e
    v_bitop3_b32 v29, v34, v35, v21 bitop3:0x7e
    v_or_b32 v28, v28, v29
    v_bitop3_b32 v29, v36, v37, v21 bitop3:0x7e
    v_or_b32 v28, v28, v29
    v_xor_b32 v29, s58, v38
    v_and_or_b32 v28, v28, v22, v29
    v_cmp_ne_u32 vcc, 0, v28
    s_cbranch_vccz L_ex2_ok
    buffer_load_dwordx4 v[32:35], v120, s[40:43], s52 offen sc1
    buffer_load_dwordx4 v[36:39], v121, s[40:43], s52 offen offset:512 sc1
    s_waitcnt vmcnt(0)
    v_bitop3_b32 v28, v32, v33, v21 bitop3:0x7e
    v_bitop3_b32 v29, v34, v35, v21 bitop3:0x7e
    v_or_b32 v28, v28, v29
    v_bitop3_b32 v29, v36, v37, v21 bitop3:0x7e
    v_or_b32 v28, v28, v29
    v_xor_b32 v29, s58, v38
    v_and_or_b32 v28, v28, v22, v29
    v_cmp_ne_u32 vcc, 0, v28
    s_cbranch_vccz L_ex2_ok
    s_sub_u32 s59, s59, 1
    s_cmp_lg_u32 s59, 0
    s_cbranch_scc1 L_ex2_retry
L_ex2_ok:
    v_and_b32 v36, v31, v36
    v_and_b32 v37, v31, v37
    v_and_b32 v32, v31, v32
    v_max_f32_dpp v44, v36, v36 row_ror:8 row_mask:0xf bank_mask:0xf
    v_and_b32 v33, v31, v33
    v_mov_b32 v45, v44
    v_and_b32 v34, v31, v34
    v_and_b32 v35, v31, v35
    v_permlane16_swap_b32 v44, v45
    v_max_f32 v44, v44, v45
    v_mov_b32 v45, v44
    s_nop 1
    v_permlane32_swap_b32 v44, v45
    v_max_f32 v44, v44, v45
    v_sub_f32 v44, v36, v44
    v_mul_f32 v44, 0x3fb8aa3b, v44
    v_exp_f32 v44, v44
    s_nop 0
    v_mul_f32 v37, v37, v44
    v_mul_f32 v32, v32, v44
    v_mul_f32 v33, v33, v44
    v_mul_f32 v34, v34, v44
    v_mul_f32 v35, v35, v44
    v_mov_b32 v45, v37
    s_nop 1
    v_permlane16_swap_b32 v37, v45
    v_permlane16_swap_b32 v32, v33
    v_permlane16_swap_b32 v34, v35
    v_add_f32 v37, v37, v45
    v_add_f32 v32, v32, v33
    v_add_f32 v34, v34, v35
    v_mov_b32 v45, v37
    s_nop 0
    v_permlane32_swap_b32 v32, v34
    v_permlane32_swap_b32 v37, v45
    v_add_f32 v32, v32, v34
    v_add_f32 v37, v37, v45
    s_nop 0
    v_add_f32_dpp v32, v32, v32 row_ror:8 row_mask:0xf bank_mask:0xf
    v_add_f32_dpp v37, v37, v37 row_ror:8 row_mask:0xf bank_mask:0xf
    v_rcp_f32 v37, v37
    s_nop 0
    v_mul_f32 v32, v32, v37
    v_cvt_pk_bf16_f32 v32, v32, v32
    s_nop 1
    v_and_b32_dpp v48, v32, v10 row_newbcast:0 row_mask:0xf bank_mask:0xf
    v_and_b32_dpp v49, v32, v11 row_newbcast:0 row_mask:0xf bank_mask:0xf
    v_and_b32_dpp v50, v32, v12 row_newbcast:0 row_mask:0xf bank_mask:0xf
    v_and_b32_dpp v51, v32, v13 row_newbcast:0 row_mask:0xf bank_mask:0xf
    v_and_b32_dpp v52, v32, v10 row_newbcast:1 row_mask:0xf bank_mask:0xf
    v_and_b32_dpp v53, v32, v11 row_newbcast:1 row_mask:0xf bank_mask:0xf
    v_and_b32_dpp v54, v32, v12 row_newbcast:1 row_mask:0xf bank_mask:0xf
    v_and_b32_dpp v55, v32, v13 row_newbcast:1 row_mask:0xf bank_mask:0xf
    s_waitcnt vmcnt(11)
    v_mfma_f32_16x16x32_bf16 v[116:119], v[48:51], v[144:147], v[116:119]
    v_and_b32_dpp v56, v32, v10 row_newbcast:2 row_mask:0xf bank_mask:0xf
    v_and_b32_dpp v57, v32, v11 row_newbcast:2 row_mask:0xf bank_mask:0xf
    v_and_b32_dpp v58, v32, v12 row_newbcast:2 row_mask:0xf bank_mask:0xf
    v_and_b32_dpp v59, v32, v13 row_newbcast:2 row_mask:0xf bank_mask:0xf
    s_waitcnt vmcnt(10)
    v_mfma_f32_16x16x32_bf16 v[116:119], v[52:55], v[148:151], v[116:119]
    v_and_b32_dpp v60, v32, v10 row_newbcast:3 row_mask:0xf bank_mask:0xf
    v_and_b32_dpp v61, v32, v11 row_newbcast:3 row_mask:0xf bank_mask:0xf
    v_and_b32_dpp v62, v32, v12 row_newbcast:3 row_mask:0xf bank_mask:0xf
    v_and_b32_dpp v63, v32, v13 row_newbcast:3 row_mask:0xf bank_mask:0xf
    s_waitcnt vmcnt(9)
    v_mfma_f32_16x16x32_bf16 v[116:119], v[56:59], v[152:155], v[116:119]
    v_and_b32_dpp v64, v32, v10 row_newbcast:4 row_mask:0xf bank_mask:0xf
    v_and_b32_dpp v65, v32, v11 row_newbcast:4 row_mask:0xf bank_mask:0xf
    v_and_b32_dpp v66, v32, v12 row_newbcast:4 row_mask:0xf bank_mask:0xf
    v_and_b32_dpp v67, v32, v13 row_newbcast:4 row_mask:0xf bank_mask:0xf
    s_waitcnt vmcnt(6)
    v_mfma_f32_16x16x32_bf16 v[116:119], v[60:63], v[156:159], v[116:119]
    v_and_b32_dpp v68, v32, v10 row_newbcast:5 row_mask:0xf bank_mask:0xf
    v_and_b32_dpp v69, v32, v11 row_newbcast:5 row_mask:0xf bank_mask:0xf
    v_and_b32_dpp v70, v32, v12 row_newbcast:5 row_mask:0xf bank_mask:0xf
    v_and_b32_dpp v71, v32, v13 row_newbcast:5 row_mask:0xf bank_mask:0xf
    s_waitcnt vmcnt(5)
    v_mfma_f32_16x16x32_bf16 v[116:119], v[64:67], v[160:163], v[116:119]
    v_and_b32_dpp v72, v32, v10 row_newbcast:6 row_mask:0xf bank_mask:0xf
    v_and_b32_dpp v73, v32, v11 row_newbcast:6 row_mask:0xf bank_mask:0xf
    v_and_b32_dpp v74, v32, v12 row_newbcast:6 row_mask:0xf bank_mask:0xf
    v_and_b32_dpp v75, v32, v13 row_newbcast:6 row_mask:0xf bank_mask:0xf
    s_waitcnt vmcnt(4)
    v_mfma_f32_16x16x32_bf16 v[116:119], v[68:71], v[164:167], v[116:119]
    v_and_b32_dpp v76, v32, v10 row_newbcast:7 row_mask:0xf bank_mask:0xf
    v_and_b32_dpp v77, v32, v11 row_newbcast:7 row_mask:0xf bank_mask:0xf
    v_and_b32_dpp v78, v32, v12 row_newbcast:7 row_mask:0xf bank_mask:0xf
    v_and_b32_dpp v79, v32, v13 row_newbcast:7 row_mask:0xf bank_mask:0xf
    s_waitcnt vmcnt(3)
    v_mfma_f32_16x16x32_bf16 v[116:119], v[72:75], v[168:171], v[116:119]
    s_waitcnt vmcnt(2)
    v_mfma_f32_16x16x32_bf16 v[116:119], v[76:79], v[172:175], v[116:119]
    s_mov_b32 exec_hi, 0
    s_nop 6
    ds_write_b128 v20, v[116:119] offset:7424
    s_mov_b64 exec, -1
    s_waitcnt lgkmcnt(0)
    s_barrier
    s_mov_b32 exec_hi, 0
    s_mov_b32 exec_lo, 0x1f
    ds_read_b128 v[32:35], v23 offset:7424
    ds_read_b128 v[36:39], v23 offset:7936
    ds_read_b128 v[40:43], v23 offset:8448
    ds_read_b128 v[44:47], v23 offset:8960
    s_waitcnt lgkmcnt(0)
    v_pk_add_f32 v[32:33], v[32:33], v[36:37]
    v_pk_add_f32 v[34:35], v[34:35], v[38:39]
    v_pk_add_f32 v[40:41], v[40:41], v[44:45]
    v_pk_add_f32 v[42:43], v[42:43], v[46:47]
    v_pk_add_f32 v[32:33], v[32:33], v[40:41]
    v_pk_add_f32 v[34:35], v[34:35], v[42:43]
    v_perm_b32 v24, v32, v21, s66
    v_perm_b32 v25, v33, v21, s66
    v_perm_b32 v26, v34, v21, s66
    v_perm_b32 v27, v35, v21, s66
    buffer_store_dwordx4 v[24:27], v19, s[40:43], s53 offen sc1
    s_mov_b64 exec, -1
    s_cmp_lg_u32 s46, 0
    s_cbranch_scc1 L_fin
    s_cmp_ge_u32 s44, 5
    s_cbranch_scc1 L_fin
    v_lshlrev_b32 v20, 4, v1
    v_and_b32 v23, 3, v1
    s_mul_i32 s53, s45, 5
    s_add_u32 s53, s53, s44
    s_lshl_b32 s53, s53, 11
    s_add_u32 s53, s53, 851968
    s_add_u32 s50, s53, 1024
    v_lshlrev_b32 v23, 3, v23
    v_lshl_add_u32 v23, v3, 1, v23
    s_mul_i32 s59, s45, 160
    s_lshl_b32 s60, s44, 5
    s_add_u32 s60, s60, s59
    v_add_u32 v30, s60, v23
    ds_read_u16 v30, v30 offset:0
    s_mov_b32 s59, 131072
    v_mov_b32 v31, 0xffffff00
    buffer_load_dwordx4 v[64:67], v20, s[40:43], s53 offen sc1
    buffer_load_dwordx4 v[68:71], v20, s[40:43], s50 offen sc1
    buffer_load_dwordx4 v[72:75], v20, s[40:43], s53 offen sc1
    buffer_load_dwordx4 v[76:79], v20, s[40:43], s50 offen sc1
    buffer_load_dwordx4 v[80:83], v20, s[40:43], s53 offen sc1
    buffer_load_dwordx4 v[84:87], v20, s[40:43], s50 offen sc1
    buffer_load_dwordx4 v[88:91], v20, s[40:43], s53 offen sc1
    buffer_load_dwordx4 v[92:95], v20, s[40:43], s50 offen sc1
L_ex3_retry:
    buffer_load_dwordx4 v[96:99], v20, s[40:43], s53 offen sc1
    buffer_load_dwordx4 v[100:103], v20, s[40:43], s50 offen sc1
    s_waitcnt vmcnt(8)
    v_bitop3_b32 v28, v64, v65, v21 bitop3:0x7e
    v_bitop3_b32 v29, v66, v67, v21 bitop3:0x7e
    v_or_b32 v28, v28, v29
    v_bitop3_b32 v29, v68, v69, v21 bitop3:0x7e
    v_or_b32 v28, v28, v29
    v_bitop3_b32 v29, v70, v71, v21 bitop3:0x7e
    v_or_b32 v28, v28, v29
    v_and_b32 v28, v28, v22
    v_cmp_ne_u32 vcc, 0, v28
    s_cbranch_vccz L_ex3_ok0
    buffer_load_dwordx4 v[64:67], v20, s[40:43], s53 offen sc1
    buffer_load_dwordx4 v[68:71], v20, s[40:43], s50 offen sc1
    s_waitcnt vmcnt(8)
    v_bitop3_b32 v28, v72, v73, v21 bitop3:0x7e
    v_bitop3_b32 v29, v74, v75, v21 bitop3:0x7e
    v_or_b32 v28, v28, v29
    v_bitop3_b32 v29, v76, v77, v21 bitop3:0x7e
    v_or_b32 v28, v28, v29
    v_bitop3_b32 v29, v78, v79, v21 bitop3:0x7e
    v_or_b32 v28, v28, v29
    v_and_b32 v28, v28, v22
    v_cmp_ne_u32 vcc, 0, v28
    s_cbranch_vccz L_ex3_ok1
    buffer_load_dwordx4 v[72:75], v20, s[40:43], s53 offen sc1
    buffer_load_dwordx4 v[76:79], v20, s[40:43], s50 offen sc1
    s_waitcnt vmcnt(8)
    v_bitop3_b32 v28, v80, v81, v21 bitop3:0x7e
    v_bitop3_b32 v29, v82, v83, v21 bitop3:0x7e
    v_or_b32 v28, v28, v29
    v_bitop3_b32 v29, v84, v85, v21 bitop3:0x7e
    v_or_b32 v28, v28, v29
    v_bitop3_b32 v29, v86, v87, v21 bitop3:0x7e
    v_or_b32 v28, v28, v29
    v_and_b32 v28, v28, v22
    v_cmp_ne_u32 vcc, 0, v28
    s_cbranch_vccz L_ex3_ok2
    buffer_load_dwordx4 v[80:83], v20, s[40:43], s53 offen sc1
    buffer_load_dwordx4 v[84:87], v20, s[40:43], s50 offen sc1
    s_waitcnt vmcnt(8)
    v_bitop3_b32 v28, v88, v89, v21 bitop3:0x7e
    v_bitop3_b32 v29, v90, v91, v21 bitop3:0x7e
    v_or_b32 v28, v28, v29
    v_bitop3_b32 v29, v92, v93, v21 bitop3:0x7e
    v_or_b32 v28, v28, v29
    v_bitop3_b32 v29, v94, v95, v21 bitop3:0x7e
    v_or_b32 v28, v28, v29
    v_and_b32 v28, v28, v22
    v_cmp_ne_u32 vcc, 0, v28
    s_cbranch_vccz L_ex3_ok3
    buffer_load_dwordx4 v[88:91], v20, s[40:43], s53 offen sc1
    buffer_load_dwordx4 v[92:95], v20, s[40:43], s50 offen sc1
    s_waitcnt vmcnt(8)
    v_bitop3_b32 v28, v96, v97, v21 bitop3:0x7e
    v_bitop3_b32 v29, v98, v99, v21 bitop3:0x7e
    v_or_b32 v28, v28, v29
    v_bitop3_b32 v29, v100, v101, v21 bitop3:0x7e
    v_or_b32 v28, v28, v29
    v_bitop3_b32 v29, v102, v103, v21 bitop3:0x7e
    v_or_b32 v28, v28, v29
    v_and_b32 v28, v28, v22
    v_cmp_ne_u32 vcc, 0, v28
    s_cbranch_vccz L_ex3_ok4
    s_sub_u32 s59, s59, 1
    s_cmp_lg_u32 s59, 0
    s_cbranch_scc1 L_ex3_retry
L_ex3_ok4:
    v_and_b32 v48, v31, v96
    v_and_b32 v49, v31, v97
    v_and_b32 v50, v31, v98
    v_and_b32 v51, v31, v99
    v_and_b32 v52, v31, v100
    v_and_b32 v53, v31, v101
    v_and_b32 v54, v31, v102
    v_and_b32 v55, v31, v103
    s_branch L_ex3_fin
L_ex3_ok3:
    v_and_b32 v48, v31, v88
    v_and_b32 v49, v31, v89
    v_and_b32 v50, v31, v90
    v_and_b32 v51, v31, v91
    v_and_b32 v52, v31, v92
    v_and_b32 v53, v31, v93
    v_and_b32 v54, v31, v94
    v_and_b32 v55, v31, v95
    s_branch L_ex3_fin
L_ex3_ok2:
    v_and_b32 v48, v31, v80
    v_and_b32 v49, v31, v81
    v_and_b32 v50, v31, v82
    v_and_b32 v51, v31, v83
    v_and_b32 v52, v31, v84
    v_and_b32 v53, v31, v85
    v_and_b32 v54, v31, v86
    v_and_b32 v55, v31, v87
    s_branch L_ex3_fin
L_ex3_ok1:
    v_and_b32 v48, v31, v72
    v_and_b32 v49, v31, v73
    v_and_b32 v50, v31, v74
    v_and_b32 v51, v31, v75
    v_and_b32 v52, v31, v76
    v_and_b32 v53, v31, v77
    v_and_b32 v54, v31, v78
    v_and_b32 v55, v31, v79
    s_branch L_ex3_fin
L_ex3_ok0:
    v_and_b32 v48, v31, v64
    v_and_b32 v49, v31, v65
    v_and_b32 v50, v31, v66
    v_and_b32 v51, v31, v67
    v_and_b32 v52, v31, v68
    v_and_b32 v53, v31, v69
    v_and_b32 v54, v31, v70
    v_and_b32 v55, v31, v71
L_ex3_fin:
    v_add_f32 v48, v48, v52
    v_add_f32 v49, v49, v53
    v_add_f32 v50, v50, v54
    v_add_f32 v51, v51, v55
    v_permlane16_swap_b32 v48, v49
    s_nop 0
    v_permlane16_swap_b32 v50, v51
    v_add_f32 v48, v48, v49
    v_add_f32 v50, v50, v51
    s_nop 1
    v_permlane32_swap_b32 v48, v50
    v_add_f32 v48, v48, v50
    s_nop 1
    v_add_f32_dpp v48, v48, v48 row_ror:4 row_mask:0xf bank_mask:0xf
    s_nop 1
    v_add_f32_dpp v48, v48, v48 row_ror:8 row_mask:0xf bank_mask:0xf
    s_waitcnt lgkmcnt(0)
    v_lshlrev_b32 v30, 16, v30
    v_add_f32 v48, v48, v30
    v_cvt_pk_bf16_f32 v48, v48, v48
    s_mov_b32 exec_hi, 0x000f000f
    s_mov_b32 exec_lo, 0x000f000f
    buffer_store_short v48, v23, s[32:35], s60 offen
    s_or_b32 s50, s44, s45
    s_cmp_lg_u32 s50, 0
    s_cbranch_scc1 L_noepoch
    s_mov_b32 exec_lo, 1
    s_mov_b32 exec_hi, 0
    v_mov_b32 v29, 0
    v_mov_b32 v31, s58
    buffer_store_dword v31, v29, s[40:43], 0 offen
L_noepoch:
    s_mov_b64 exec, -1
L_fin:
    s_endpgm
L_kv:
    s_load_dwordx2 s[8:9], s[0:1], 8
    s_load_dwordx2 s[12:13], s[0:1], 16
    s_sub_u32 s46, s46, 4
    s_mov_b32 s10, 67108864
    s_mov_b32 s11, 0x20000
    s_mov_b32 s14, 67108864
    s_mov_b32 s15, 0x20000
    v_lshlrev_b32 v4, 4, v1
    s_lshl_b32 s48, s44, 21
    s_lshl_b32 s53, s45, 16
    s_add_u32 s48, s48, s53
    s_lshl_b32 s53, s46, 14
    s_add_u32 s48, s48, s53
    s_add_u32 s48, s48, 1572864
    s_mov_b32 s49, s44
    s_mul_i32 s53, s46, 4
    s_add_u32 s49, s49, s53
    s_and_b32 s49, s49, 15
    s_lshl_b32 s49, s49, 10
    s_waitcnt lgkmcnt(0)
    s_add_u32 s50, s48, s49
    s_add_u32 s49, s49, 1024
    s_and_b32 s49, s49, 16383
    buffer_load_dwordx4 v[32:35], v4, s[8:11], s50 offen nt
    s_add_u32 s50, s48, s49
    s_add_u32 s49, s49, 1024
    s_and_b32 s49, s49, 16383
    buffer_load_dwordx4 v[36:39], v4, s[8:11], s50 offen nt
    s_add_u32 s50, s48, s49
    s_add_u32 s49, s49, 1024
    s_and_b32 s49, s49, 16383
    buffer_load_dwordx4 v[40:43], v4, s[8:11], s50 offen nt
    s_add_u32 s50, s48, s49
    s_add_u32 s49, s49, 1024
    s_and_b32 s49, s49, 16383
    buffer_load_dwordx4 v[44:47], v4, s[8:11], s50 offen nt
    v_and_b32 v17, 1, v2
    v_lshlrev_b32 v17, 4, v17
    v_mov_b32 v18, 0xffff
    v_lshlrev_b32 v17, v17, v18
    v_lshrrev_b32 v18, 1, v2
    v_cmp_eq_u32 vcc, 0, v18
    s_nop 1
    v_cndmask_b32 v10, 0, v17, vcc
    v_cmp_eq_u32 vcc, 1, v18
    s_nop 1
    v_cndmask_b32 v11, 0, v17, vcc
    v_cmp_eq_u32 vcc, 2, v18
    s_nop 1
    v_cndmask_b32 v12, 0, v17, vcc
    v_cmp_eq_u32 vcc, 3, v18
    s_nop 1
    v_cndmask_b32 v13, 0, v17, vcc
    v_lshlrev_b32 v9, 5, v2
    v_lshl_add_u32 v9, v3, 4, v9
    s_mov_b32 s60, 0xaaaaaaaa
    s_mov_b32 s61, 0xaaaaaaaa
    s_mov_b32 s62, 0xcccccccc
    s_mov_b32 s63, 0xcccccccc
    s_add_u32 s50, s48, s49
    s_add_u32 s49, s49, 1024
    s_and_b32 s49, s49, 16383
    buffer_load_dwordx4 v[48:51], v4, s[8:11], s50 offen nt
    s_add_u32 s50, s48, s49
    s_add_u32 s49, s49, 1024
    s_and_b32 s49, s49, 16383
    buffer_load_dwordx4 v[52:55], v4, s[8:11], s50 offen nt
    s_waitcnt vmcnt(5)
    s_add_u32 s50, s48, s49
    s_add_u32 s49, s49, 1024
    s_and_b32 s49, s49, 16383
    buffer_load_dwordx4 v[56:59], v4, s[8:11], s50 offen nt
    s_waitcnt vmcnt(5)
    s_add_u32 s50, s48, s49
    s_add_u32 s49, s49, 1024
    s_and_b32 s49, s49, 16383
    buffer_load_dwordx4 v[60:63], v4, s[8:11], s50 offen nt
    s_waitcnt vmcnt(5)
    s_add_u32 s50, s48, s49
    s_add_u32 s49, s49, 1024
    s_and_b32 s49, s49, 16383
    buffer_load_dwordx4 v[64:67], v4, s[8:11], s50 offen nt
    s_waitcnt vmcnt(5)
    s_add_u32 s50, s48, s49
    s_add_u32 s49, s49, 1024
    s_and_b32 s49, s49, 16383
    buffer_load_dwordx4 v[68:71], v4, s[8:11], s50 offen nt
    s_waitcnt vmcnt(5)
    s_add_u32 s50, s48, s49
    s_add_u32 s49, s49, 1024
    s_and_b32 s49, s49, 16383
    buffer_load_dwordx4 v[72:75], v4, s[8:11], s50 offen nt
    s_waitcnt vmcnt(5)
    s_add_u32 s50, s48, s49
    s_add_u32 s49, s49, 1024
    s_and_b32 s49, s49, 16383
    buffer_load_dwordx4 v[76:79], v4, s[8:11], s50 offen nt
    s_waitcnt vmcnt(5)
    s_add_u32 s50, s48, s49
    s_add_u32 s49, s49, 1024
    s_and_b32 s49, s49, 16383
    buffer_load_dwordx4 v[80:83], v4, s[8:11], s50 offen nt
    s_waitcnt vmcnt(5)
    s_add_u32 s50, s48, s49
    s_add_u32 s49, s49, 1024
    s_and_b32 s49, s49, 16383
    buffer_load_dwordx4 v[84:87], v4, s[8:11], s50 offen nt
    s_waitcnt vmcnt(5)
    s_add_u32 s50, s48, s49
    s_add_u32 s49, s49, 1024
    s_and_b32 s49, s49, 16383
    buffer_load_dwordx4 v[88:91], v4, s[8:11], s50 offen nt
    s_barrier
    s_waitcnt vmcnt(5)
    s_add_u32 s50, s48, s49
    s_add_u32 s49, s49, 1024
    s_and_b32 s49, s49, 16383
    buffer_load_dwordx4 v[92:95], v4, s[8:11], s50 offen nt
    s_waitcnt vmcnt(5)
    s_add_u32 s50, s48, s49
    s_add_u32 s49, s49, 1024
    s_and_b32 s49, s49, 16383
    buffer_load_dwordx4 v[96:99], v4, s[12:15], s50 offen nt
    s_waitcnt vmcnt(5)
    s_add_u32 s50, s48, s49
    s_add_u32 s49, s49, 1024
    s_and_b32 s49, s49, 16383
    buffer_load_dwordx4 v[100:103], v4, s[12:15], s50 offen nt
    s_waitcnt vmcnt(5)
    s_add_u32 s50, s48, s49
    s_add_u32 s49, s49, 1024
    s_and_b32 s49, s49, 16383
    buffer_load_dwordx4 v[104:107], v4, s[12:15], s50 offen nt
    s_waitcnt vmcnt(5)
    s_add_u32 s50, s48, s49
    s_add_u32 s49, s49, 1024
    s_and_b32 s49, s49, 16383
    buffer_load_dwordx4 v[108:111], v4, s[12:15], s50 offen nt
    s_waitcnt vmcnt(5)
    s_add_u32 s50, s48, s49
    s_add_u32 s49, s49, 1024
    s_and_b32 s49, s49, 16383
    buffer_load_dwordx4 v[112:115], v4, s[12:15], s50 offen nt
    s_waitcnt vmcnt(5)
    s_add_u32 s50, s48, s49
    s_add_u32 s49, s49, 1024
    s_and_b32 s49, s49, 16383
    buffer_load_dwordx4 v[116:119], v4, s[12:15], s50 offen nt
    s_waitcnt vmcnt(5)
    s_add_u32 s50, s48, s49
    s_add_u32 s49, s49, 1024
    s_and_b32 s49, s49, 16383
    buffer_load_dwordx4 v[120:123], v4, s[12:15], s50 offen nt
    s_waitcnt vmcnt(5)
    s_add_u32 s50, s48, s49
    s_add_u32 s49, s49, 1024
    s_and_b32 s49, s49, 16383
    buffer_load_dwordx4 v[124:127], v4, s[12:15], s50 offen nt
    s_waitcnt vmcnt(5)
    s_add_u32 s50, s48, s49
    s_add_u32 s49, s49, 1024
    s_and_b32 s49, s49, 16383
    buffer_load_dwordx4 v[128:131], v4, s[12:15], s50 offen nt
    s_waitcnt vmcnt(5)
    s_add_u32 s50, s48, s49
    s_add_u32 s49, s49, 1024
    s_and_b32 s49, s49, 16383
    buffer_load_dwordx4 v[132:135], v4, s[12:15], s50 offen nt
    v_lshlrev_b32 v28, 4, v2
    s_barrier
    ds_read_b128 v[20:23], v28 offset:4608
    s_waitcnt vmcnt(10)
    s_waitcnt lgkmcnt(0)
    s_add_u32 s50, s48, s49
    s_add_u32 s49, s49, 1024
    s_and_b32 s49, s49, 16383
    buffer_load_dwordx4 v[136:139], v4, s[12:15], s50 offen nt
    s_add_u32 s50, s48, s49
    s_add_u32 s49, s49, 1024
    s_and_b32 s49, s49, 16383
    buffer_load_dwordx4 v[140:143], v4, s[12:15], s50 offen nt
    v_dot2_f32_bf16 v160, v32, v20, 0
    v_dot2_f32_bf16 v161, v36, v20, 0
    v_dot2_f32_bf16 v162, v40, v20, 0
    v_dot2_f32_bf16 v163, v44, v20, 0
    v_dot2_f32_bf16 v164, v48, v20, 0
    v_dot2_f32_bf16 v165, v52, v20, 0
    v_dot2_f32_bf16 v166, v56, v20, 0
    v_dot2_f32_bf16 v167, v60, v20, 0
    v_dot2_f32_bf16 v168, v64, v20, 0
    v_dot2_f32_bf16 v169, v68, v20, 0
    v_dot2_f32_bf16 v170, v72, v20, 0
    v_dot2_f32_bf16 v171, v76, v20, 0
    v_dot2_f32_bf16 v172, v80, v20, 0
    v_dot2_f32_bf16 v173, v84, v20, 0
    v_dot2_f32_bf16 v174, v88, v20, 0
    v_dot2_f32_bf16 v175, v92, v20, 0
    s_add_u32 s50, s48, s49
    s_add_u32 s49, s49, 1024
    s_and_b32 s49, s49, 16383
    buffer_load_dwordx4 v[144:147], v4, s[12:15], s50 offen nt
    s_add_u32 s50, s48, s49
    s_add_u32 s49, s49, 1024
    s_and_b32 s49, s49, 16383
    buffer_load_dwordx4 v[148:151], v4, s[12:15], s50 offen nt
    v_dot2c_f32_bf16 v160, v33, v21
    v_dot2c_f32_bf16 v161, v37, v21
    v_dot2c_f32_bf16 v162, v41, v21
    v_dot2c_f32_bf16 v163, v45, v21
    v_dot2c_f32_bf16 v164, v49, v21
    v_dot2c_f32_bf16 v165, v53, v21
    v_dot2c_f32_bf16 v166, v57, v21
    v_dot2c_f32_bf16 v167, v61, v21
    v_dot2c_f32_bf16 v168, v65, v21
    v_dot2c_f32_bf16 v169, v69, v21
    v_dot2c_f32_bf16 v170, v73, v21
    v_dot2c_f32_bf16 v171, v77, v21
    v_dot2c_f32_bf16 v172, v81, v21
    v_dot2c_f32_bf16 v173, v85, v21
    v_dot2c_f32_bf16 v174, v89, v21
    v_dot2c_f32_bf16 v175, v93, v21
    s_add_u32 s50, s48, s49
    s_add_u32 s49, s49, 1024
    s_and_b32 s49, s49, 16383
    buffer_load_dwordx4 v[152:155], v4, s[12:15], s50 offen nt
    s_add_u32 s50, s48, s49
    s_add_u32 s49, s49, 1024
    s_and_b32 s49, s49, 16383
    buffer_load_dwordx4 v[156:159], v4, s[12:15], s50 offen nt
    v_dot2c_f32_bf16 v160, v34, v22
    v_dot2c_f32_bf16 v161, v38, v22
    v_dot2c_f32_bf16 v162, v42, v22
    v_dot2c_f32_bf16 v163, v46, v22
    v_dot2c_f32_bf16 v164, v50, v22
    v_dot2c_f32_bf16 v165, v54, v22
    v_dot2c_f32_bf16 v166, v58, v22
    v_dot2c_f32_bf16 v167, v62, v22
    v_dot2c_f32_bf16 v168, v66, v22
    v_dot2c_f32_bf16 v169, v70, v22
    v_dot2c_f32_bf16 v170, v74, v22
    v_dot2c_f32_bf16 v171, v78, v22
    v_dot2c_f32_bf16 v172, v82, v22
    v_dot2c_f32_bf16 v173, v86, v22
    v_dot2c_f32_bf16 v174, v90, v22
    v_dot2c_f32_bf16 v175, v94, v22
    v_dot2c_f32_bf16 v160, v35, v23
    v_dot2c_f32_bf16 v161, v39, v23
    v_dot2c_f32_bf16 v162, v43, v23
    v_dot2c_f32_bf16 v163, v47, v23
    v_dot2c_f32_bf16 v164, v51, v23
    v_dot2c_f32_bf16 v165, v55, v23
    v_dot2c_f32_bf16 v166, v59, v23
    v_dot2c_f32_bf16 v167, v63, v23
    v_dot2c_f32_bf16 v168, v67, v23
    v_dot2c_f32_bf16 v169, v71, v23
    v_dot2c_f32_bf16 v170, v75, v23
    v_dot2c_f32_bf16 v171, v79, v23
    v_dot2c_f32_bf16 v172, v83, v23
    v_dot2c_f32_bf16 v173, v87, v23
    v_dot2c_f32_bf16 v174, v91, v23
    v_dot2c_f32_bf16 v175, v95, v23
    v_add_f32_dpp v160, v160, v160 row_ror:8 row_mask:0xf bank_mask:0x3
    v_add_f32_dpp v161, v161, v161 row_ror:8 row_mask:0xf bank_mask:0x3
    v_add_f32_dpp v162, v162, v162 row_ror:8 row_mask:0xf bank_mask:0x3
    v_add_f32_dpp v163, v163, v163 row_ror:8 row_mask:0xf bank_mask:0x3
    v_add_f32_dpp v164, v164, v164 row_ror:8 row_mask:0xf bank_mask:0x3
    v_add_f32_dpp v165, v165, v165 row_ror:8 row_mask:0xf bank_mask:0x3
    v_add_f32_dpp v166, v166, v166 row_ror:8 row_mask:0xf bank_mask:0x3
    v_add_f32_dpp v167, v167, v167 row_ror:8 row_mask:0xf bank_mask:0x3
    v_add_f32_dpp v160, v168, v168 row_ror:8 row_mask:0xf bank_mask:0xc
    v_add_f32_dpp v161, v169, v169 row_ror:8 row_mask:0xf bank_mask:0xc
    v_add_f32_dpp v162, v170, v170 row_ror:8 row_mask:0xf bank_mask:0xc
    v_add_f32_dpp v163, v171, v171 row_ror:8 row_mask:0xf bank_mask:0xc
    v_add_f32_dpp v164, v172, v172 row_ror:8 row_mask:0xf bank_mask:0xc
    v_add_f32_dpp v165, v173, v173 row_ror:8 row_mask:0xf bank_mask:0xc
    v_add_f32_dpp v166, v174, v174 row_ror:8 row_mask:0xf bank_mask:0xc
    v_add_f32_dpp v167, v175, v175 row_ror:8 row_mask:0xf bank_mask:0xc
    v_add_f32_dpp v160, v160, v160 row_half_mirror row_mask:0xf bank_mask:0x5
    v_add_f32_dpp v161, v161, v161 row_half_mirror row_mask:0xf bank_mask:0x5
    v_add_f32_dpp v162, v162, v162 row_half_mirror row_mask:0xf bank_mask:0x5
    v_add_f32_dpp v163, v163, v163 row_half_mirror row_mask:0xf bank_mask:0x5
    v_add_f32_dpp v160, v164, v164 row_half_mirror row_mask:0xf bank_mask:0xa
    v_add_f32_dpp v161, v165, v165 row_half_mirror row_mask:0xf bank_mask:0xa
    v_add_f32_dpp v162, v166, v166 row_half_mirror row_mask:0xf bank_mask:0xa
    v_add_f32_dpp v163, v167, v167 row_half_mirror row_mask:0xf bank_mask:0xa
    v_add_f32_dpp v160, v160, v160 quad_perm:[1,0,3,2] row_mask:0xf bank_mask:0xf
    v_add_f32_dpp v161, v161, v161 quad_perm:[1,0,3,2] row_mask:0xf bank_mask:0xf
    v_add_f32_dpp v162, v162, v162 quad_perm:[1,0,3,2] row_mask:0xf bank_mask:0xf
    v_add_f32_dpp v163, v163, v163 quad_perm:[1,0,3,2] row_mask:0xf bank_mask:0xf
    v_cndmask_b32 v160, v160, v162, s[60:61]
    v_cndmask_b32 v161, v161, v163, s[60:61]
    s_nop 0
    v_add_f32_dpp v160, v160, v160 quad_perm:[2,3,0,1] row_mask:0xf bank_mask:0xf
    v_add_f32_dpp v161, v161, v161 quad_perm:[2,3,0,1] row_mask:0xf bank_mask:0xf
    v_cndmask_b32 v160, v160, v161, s[62:63]
    v_cvt_pk_bf16_f32 v160, v160, v160
    v_and_b32 v160, 0xffff0000, v160
    v_mul_f32 v160, 0x3db504f3, v160
    v_cvt_pk_bf16_f32 v160, v160, v160
    v_and_b32 v160, 0xffff0000, v160
    s_nop 1
    v_max_f32_dpp v161, v160, v160 quad_perm:[1,0,3,2] row_mask:0xf bank_mask:0xf
    s_nop 1
    v_max_f32_dpp v161, v161, v161 quad_perm:[2,3,0,1] row_mask:0xf bank_mask:0xf
    s_nop 1
    v_max_f32_dpp v161, v161, v161 row_half_mirror row_mask:0xf bank_mask:0xf
    s_nop 1
    v_max_f32_dpp v161, v161, v161 row_mirror row_mask:0xf bank_mask:0xf
    s_nop 1
    v_max_f32_dpp v161, v161, v161 row_bcast:15 row_mask:0xa bank_mask:0xf
    s_nop 1
    v_max_f32_dpp v161, v161, v161 row_bcast:31 row_mask:0xc bank_mask:0xf
    s_lshl_b32 s53, s46, 2
    v_mov_b32 v162, s53
    s_mov_b32 exec_lo, 0
    s_mov_b32 exec_hi, 0x80000000
    ds_write_b32 v162, v161 offset:4864
    s_mov_b64 exec, -1
    v_mov_b32 v162, 4864
    s_waitcnt lgkmcnt(0)
    s_barrier
    ds_read_b128 v[164:167], v162
    s_waitcnt lgkmcnt(0)
    v_max3_f32 v164, v164, v165, v166
    v_max_f32 v164, v164, v167
    v_sub_f32 v160, v160, v164
    v_mul_f32 v160, 0x3fb8aa3b, v160
    v_exp_f32 v160, v160
    s_nop 0
    v_cvt_pk_bf16_f32 v161, v160, v160
    s_nop 1
    v_and_b32_dpp v32, v161, v10 row_newbcast:0 row_mask:0xf bank_mask:0xf
    v_and_b32_dpp v33, v161, v11 row_newbcast:0 row_mask:0xf bank_mask:0xf
    v_and_b32_dpp v34, v161, v12 row_newbcast:0 row_mask:0xf bank_mask:0xf
    v_and_b32_dpp v35, v161, v13 row_newbcast:0 row_mask:0xf bank_mask:0xf
    v_add_f32_dpp v160, v160, v160 quad_perm:[1,0,3,2] row_mask:0xf bank_mask:0xf
    v_and_b32_dpp v36, v161, v10 row_newbcast:2 row_mask:0xf bank_mask:0xf
    v_and_b32_dpp v37, v161, v11 row_newbcast:2 row_mask:0xf bank_mask:0xf
    v_and_b32_dpp v38, v161, v12 row_newbcast:2 row_mask:0xf bank_mask:0xf
    v_and_b32_dpp v39, v161, v13 row_newbcast:2 row_mask:0xf bank_mask:0xf
    v_add_f32_dpp v160, v160, v160 quad_perm:[2,3,0,1] row_mask:0xf bank_mask:0xf
    s_waitcnt vmcnt(15)
    v_mfma_f32_16x16x32_bf16 v[176:179], v[32:35], v[96:99], 0
    v_and_b32_dpp v40, v161, v10 row_newbcast:1 row_mask:0xf bank_mask:0xf
    v_and_b32_dpp v41, v161, v11 row_newbcast:1 row_mask:0xf bank_mask:0xf
    v_and_b32_dpp v42, v161, v12 row_newbcast:1 row_mask:0xf bank_mask:0xf
    v_and_b32_dpp v43, v161, v13 row_newbcast:1 row_mask:0xf bank_mask:0xf
    v_add_f32_dpp v160, v160, v160 row_half_mirror row_mask:0xf bank_mask:0xf
    s_waitcnt vmcnt(14)
    v_mfma_f32_16x16x32_bf16 v[176:179], v[36:39], v[100:103], v[176:179]
    v_and_b32_dpp v44, v161, v10 row_newbcast:3 row_mask:0xf bank_mask:0xf
    v_and_b32_dpp v45, v161, v11 row_newbcast:3 row_mask:0xf bank_mask:0xf
    v_and_b32_dpp v46, v161, v12 row_newbcast:3 row_mask:0xf bank_mask:0xf
    v_and_b32_dpp v47, v161, v13 row_newbcast:3 row_mask:0xf bank_mask:0xf
    v_add_f32_dpp v160, v160, v160 row_mirror row_mask:0xf bank_mask:0xf
    s_waitcnt vmcnt(13)
    v_mfma_f32_16x16x32_bf16 v[176:179], v[40:43], v[104:107], v[176:179]
    v_and_b32_dpp v48, v161, v10 row_newbcast:4 row_mask:0xf bank_mask:0xf
    v_and_b32_dpp v49, v161, v11 row_newbcast:4 row_mask:0xf bank_mask:0xf
    v_and_b32_dpp v50, v161, v12 row_newbcast:4 row_mask:0xf bank_mask:0xf
    v_and_b32_dpp v51, v161, v13 row_newbcast:4 row_mask:0xf bank_mask:0xf
    v_add_f32_dpp v160, v160, v160 row_bcast:15 row_mask:0xa bank_mask:0xf
    s_waitcnt vmcnt(12)
    v_mfma_f32_16x16x32_bf16 v[176:179], v[44:47], v[108:111], v[176:179]
    v_and_b32_dpp v52, v161, v10 row_newbcast:6 row_mask:0xf bank_mask:0xf
    v_and_b32_dpp v53, v161, v11 row_newbcast:6 row_mask:0xf bank_mask:0xf
    v_and_b32_dpp v54, v161, v12 row_newbcast:6 row_mask:0xf bank_mask:0xf
    v_and_b32_dpp v55, v161, v13 row_newbcast:6 row_mask:0xf bank_mask:0xf
    v_add_f32_dpp v160, v160, v160 row_bcast:31 row_mask:0xc bank_mask:0xf
    s_waitcnt vmcnt(11)
    v_mfma_f32_16x16x32_bf16 v[176:179], v[48:51], v[112:115], v[176:179]
    v_and_b32_dpp v56, v161, v10 row_newbcast:5 row_mask:0xf bank_mask:0xf
    v_and_b32_dpp v57, v161, v11 row_newbcast:5 row_mask:0xf bank_mask:0xf
    v_and_b32_dpp v58, v161, v12 row_newbcast:5 row_mask:0xf bank_mask:0xf
    v_and_b32_dpp v59, v161, v13 row_newbcast:5 row_mask:0xf bank_mask:0xf
    s_waitcnt vmcnt(10)
    v_mfma_f32_16x16x32_bf16 v[176:179], v[52:55], v[116:119], v[176:179]
    v_and_b32_dpp v60, v161, v10 row_newbcast:7 row_mask:0xf bank_mask:0xf
    v_and_b32_dpp v61, v161, v11 row_newbcast:7 row_mask:0xf bank_mask:0xf
    v_and_b32_dpp v62, v161, v12 row_newbcast:7 row_mask:0xf bank_mask:0xf
    v_and_b32_dpp v63, v161, v13 row_newbcast:7 row_mask:0xf bank_mask:0xf
    s_cmp_eq_u32 s46, 0
    s_cselect_b32 s53, -1, 0
    v_and_b32 v162, s53, v164
    v_mov_b32 v163, v160
    s_mul_i32 s53, s46, 528
    v_mov_b32 v165, s53
    s_mov_b32 exec_lo, 0
    s_mov_b32 exec_hi, 0x80000000
    ds_write_b64 v165, v[162:163] offset:5632
    s_mov_b64 exec, -1
    v_add_u32 v165, s53, v9
    s_waitcnt vmcnt(9)
    v_mfma_f32_16x16x32_bf16 v[176:179], v[56:59], v[120:123], v[176:179]
    v_and_b32_dpp v64, v161, v10 row_newbcast:8 row_mask:0xf bank_mask:0xf
    v_and_b32_dpp v65, v161, v11 row_newbcast:8 row_mask:0xf bank_mask:0xf
    v_and_b32_dpp v66, v161, v12 row_newbcast:8 row_mask:0xf bank_mask:0xf
    v_and_b32_dpp v67, v161, v13 row_newbcast:8 row_mask:0xf bank_mask:0xf
    s_waitcnt vmcnt(8)
    v_mfma_f32_16x16x32_bf16 v[176:179], v[60:63], v[124:127], v[176:179]
    v_and_b32_dpp v68, v161, v10 row_newbcast:10 row_mask:0xf bank_mask:0xf
    v_and_b32_dpp v69, v161, v11 row_newbcast:10 row_mask:0xf bank_mask:0xf
    v_and_b32_dpp v70, v161, v12 row_newbcast:10 row_mask:0xf bank_mask:0xf
    v_and_b32_dpp v71, v161, v13 row_newbcast:10 row_mask:0xf bank_mask:0xf
    s_waitcnt vmcnt(7)
    v_mfma_f32_16x16x32_bf16 v[176:179], v[64:67], v[128:131], v[176:179]
    v_and_b32_dpp v72, v161, v10 row_newbcast:9 row_mask:0xf bank_mask:0xf
    v_and_b32_dpp v73, v161, v11 row_newbcast:9 row_mask:0xf bank_mask:0xf
    v_and_b32_dpp v74, v161, v12 row_newbcast:9 row_mask:0xf bank_mask:0xf
    v_and_b32_dpp v75, v161, v13 row_newbcast:9 row_mask:0xf bank_mask:0xf
    s_waitcnt vmcnt(6)
    v_mfma_f32_16x16x32_bf16 v[176:179], v[68:71], v[132:135], v[176:179]
    v_and_b32_dpp v76, v161, v10 row_newbcast:11 row_mask:0xf bank_mask:0xf
    v_and_b32_dpp v77, v161, v11 row_newbcast:11 row_mask:0xf bank_mask:0xf
    v_and_b32_dpp v78, v161, v12 row_newbcast:11 row_mask:0xf bank_mask:0xf
    v_and_b32_dpp v79, v161, v13 row_newbcast:11 row_mask:0xf bank_mask:0xf
    s_waitcnt vmcnt(5)
    v_mfma_f32_16x16x32_bf16 v[176:179], v[72:75], v[136:139], v[176:179]
    v_and_b32_dpp v80, v161, v10 row_newbcast:12 row_mask:0xf bank_mask:0xf
    v_and_b32_dpp v81, v161, v11 row_newbcast:12 row_mask:0xf bank_mask:0xf
    v_and_b32_dpp v82, v161, v12 row_newbcast:12 row_mask:0xf bank_mask:0xf
    v_and_b32_dpp v83, v161, v13 row_newbcast:12 row_mask:0xf bank_mask:0xf
    s_waitcnt vmcnt(4)
    v_mfma_f32_16x16x32_bf16 v[176:179], v[76:79], v[140:143], v[176:179]
    v_and_b32_dpp v84, v161, v10 row_newbcast:14 row_mask:0xf bank_mask:0xf
    v_and_b32_dpp v85, v161, v11 row_newbcast:14 row_mask:0xf bank_mask:0xf
    v_and_b32_dpp v86, v161, v12 row_newbcast:14 row_mask:0xf bank_mask:0xf
    v_and_b32_dpp v87, v161, v13 row_newbcast:14 row_mask:0xf bank_mask:0xf
    s_waitcnt vmcnt(3)
    v_mfma_f32_16x16x32_bf16 v[176:179], v[80:83], v[144:147], v[176:179]
    v_and_b32_dpp v88, v161, v10 row_newbcast:13 row_mask:0xf bank_mask:0xf
    v_and_b32_dpp v89, v161, v11 row_newbcast:13 row_mask:0xf bank_mask:0xf
    v_and_b32_dpp v90, v161, v12 row_newbcast:13 row_mask:0xf bank_mask:0xf
    v_and_b32_dpp v91, v161, v13 row_newbcast:13 row_mask:0xf bank_mask:0xf
    s_waitcnt vmcnt(2)
    v_mfma_f32_16x16x32_bf16 v[176:179], v[84:87], v[148:151], v[176:179]
    v_and_b32_dpp v92, v161, v10 row_newbcast:15 row_mask:0xf bank_mask:0xf
    v_and_b32_dpp v93, v161, v11 row_newbcast:15 row_mask:0xf bank_mask:0xf
    v_and_b32_dpp v94, v161, v12 row_newbcast:15 row_mask:0xf bank_mask:0xf
    v_and_b32_dpp v95, v161, v13 row_newbcast:15 row_mask:0xf bank_mask:0xf
    s_waitcnt vmcnt(1)
    v_mfma_f32_16x16x32_bf16 v[176:179], v[88:91], v[152:155], v[176:179]
    s_waitcnt vmcnt(0)
    v_mfma_f32_16x16x32_bf16 v[176:179], v[92:95], v[156:159], v[176:179]
    s_mov_b32 exec_hi, 0
    s_nop 6
    ds_write_b128 v165, v[176:179] offset:5120
    s_mov_b64 exec, -1
    s_waitcnt lgkmcnt(0)
    s_barrier
    s_endpgm
L_end:
    s_endpgm
.section .rodata,"a"
.p2align 6
.amdhsa_kernel parallel_sum__sliding_block_cached__dense_activation_silu__decode_kernel
.amdhsa_next_free_vgpr 256
.amdhsa_next_free_sgpr 102
.amdhsa_accum_offset 256
.amdhsa_group_segment_fixed_size 0
.amdhsa_kernarg_size 88
.amdhsa_user_sgpr_count 2
.amdhsa_float_denorm_mode_32 3
.amdhsa_user_sgpr_kernarg_segment_ptr 1
.amdhsa_system_sgpr_workgroup_id_x 1
.end_amdhsa_kernel
```
